```python
import torch

def _softmax(x, axis=-1):
    return torch.softmax(x, dim=axis)
def _gelu(x):
    return torch.nn.functional.gelu(x, approximate="tanh")
def _silu(x):
    return torch.nn.functional.silu(x)
def _sigmoid(x):
    return torch.sigmoid(x)
def _layernorm(x, axis=-1, eps=1e-5):
    m = x.mean(dim=axis, keepdim=True)
    v = x.var(dim=axis, keepdim=True, unbiased=False)
    return (x - m) / torch.sqrt(v + eps)
def _scatter_add(tgt, idx, src, axis=0):
    return tgt.clone().index_add_(axis, idx, src)
def _segment_sum(src, seg, n):
    out = torch.zeros((n,) + src.shape[1:], dtype=src.dtype)
    return out.index_add_(0, seg, src)
def _pad(x, pw):
    flat = tuple(v for pair in reversed(pw) for v in pair)
    return torch.nn.functional.pad(x, flat)

kernel_name = 'standalone__edge_featured_mpnn_gatedgcn__graph'

def setup_inputs():

    _w = (lambda a: (lambda t: t.to(torch.bfloat16) if t.is_floating_point() else t)(torch.as_tensor(a)))
    N, deg, D, De = 12500, 64, 64, max(16, 1)
    E = N * deg
    return {
        "x": _w((lambda *s: torch.randn(*s, dtype=torch.bfloat16) * 0.8)(N, D)),
        "e_attr": _w((lambda *s: torch.randn(*s, dtype=torch.bfloat16) * 0.8)(E, De)),
        "src": _w((lambda lo, hi, *s: torch.randint(lo, hi, s))(0, N, E).to(torch.int64)),
        "dst": _w((lambda lo, hi, *s: torch.randint(lo, hi, s))(0, N, E).to(torch.int64)),
        "w_a": _w((lambda *s: torch.randn(*s, dtype=torch.bfloat16) * 0.8)(D, D)),
        "w_b": _w((lambda *s: torch.randn(*s, dtype=torch.bfloat16) * 0.8)(D, D)),
        "w_c": _w((lambda *s: torch.randn(*s, dtype=torch.bfloat16) * 0.8)(De, D)),
        "w_u": _w((lambda *s: torch.randn(*s, dtype=torch.bfloat16) * 0.05)(D, D)),
        "w_v": _w((lambda *s: torch.randn(*s, dtype=torch.bfloat16) * 0.05)(D, D)),
    }

def reference(x, e_attr, src, dst, w_a, w_b, w_c, w_u, w_v):
    N, D = x.shape
    hv = x @ w_v
    g = x[dst] @ w_a + x[src] @ w_b + e_attr @ w_c
    eta = _sigmoid(g)
    denom = _segment_sum(eta, dst, N) + 1e-6
    eta_n = eta / denom[dst]
    agg = _segment_sum(eta_n * hv[src], dst, N)
    z = x @ w_u + agg
    relu_z = torch.where(z > 0, z, 0 * z)
    return x + relu_z
```

```asm
; @launch kernel=gcn_sort_kernel grid=(253,1,1) block=(1024,1,1) lds=49152
; @launch kernel=standalone__edge_featured_mpnn_gatedgcn__graph_kernel grid=(256,1,1) block=(512,1,1) lds=162576
.amdgcn_target "amdgcn-amd-amdhsa--gfx950"
.text

.globl gcn_sort_kernel
.p2align 8
.type gcn_sort_kernel,@function
gcn_sort_kernel:
    s_cmp_ge_u32 s2, 253
    s_cbranch_scc1 K1_END
    s_load_dwordx2 s[8:9], s[0:1], 88
    s_cmp_lt_u32 s2, 3
    s_cbranch_scc1 K1_W
    s_sub_u32 s2, s2, 3
    s_load_dwordx4 s[4:7], s[0:1], 16
    v_lshlrev_b32 v1, 4, v0
    s_mul_i32 s10, s2, 12800
    s_waitcnt lgkmcnt(0)
    s_add_u32 s16, s6, s10
    s_addc_u32 s17, s7, 0
    s_mov_b32 s18, 12800
    s_mov_b32 s19, 0x20000
    buffer_load_dwordx4 v[8:11], v1, s[16:19], 0 offen nt
    s_add_u32 s12, s4, s10
    s_addc_u32 s13, s5, 0
    s_mov_b32 s14, 12800
    s_mov_b32 s15, 0x20000
    buffer_load_dwordx4 v[12:15], v1, s[12:15], 0 offen nt
    v_mov_b32 v4, 0
    v_mov_b32 v5, 0
    v_mov_b32 v6, 0
    v_mov_b32 v7, 0
    ds_write_b128 v1, v[4:7]
    ds_write_b128 v1, v[4:7] offset:16384
    ds_write_b128 v1, v[4:7] offset:32768
    s_mul_i32 s10, s2, 25600
    s_add_u32 s24, s8, 8454144
    s_addc_u32 s25, s9, 0
    s_add_u32 s24, s24, s10
    s_addc_u32 s25, s25, 0
    s_mov_b32 s26, 25600
    s_mov_b32 s27, 0x20000
    s_mov_b32 s32, s8
    s_mov_b32 s33, s9
    s_mov_b32 s34, 0x800000
    s_mov_b32 s35, 0x20000
    s_add_u32 s40, s8, 8388608
    s_addc_u32 s41, s9, 0
    s_mov_b32 s42, 1000
    s_mov_b32 s43, 0x20000
    v_mov_b32 v2, 1
    v_mov_b32 v3, 37888
    s_waitcnt lgkmcnt(0)
    s_barrier
    v_cmp_gt_u32 vcc, 800, v0
    s_and_saveexec_b64 s[20:21], vcc
    s_cbranch_execz K1_SKIP
    s_mov_b64 s[28:29], exec
    s_waitcnt vmcnt(1)
    v_and_b32 v16, 255, v8
    v_lshlrev_b32 v24, 2, v16
    ds_add_rtn_u32 v28, v24, v2 offset:36864
    v_and_b32 v17, 255, v9
    v_lshlrev_b32 v25, 2, v17
    ds_add_rtn_u32 v29, v25, v2 offset:36864
    v_and_b32 v18, 255, v10
    v_lshlrev_b32 v26, 2, v18
    ds_add_rtn_u32 v30, v26, v2 offset:36864
    v_and_b32 v19, 255, v11
    v_lshlrev_b32 v27, 2, v19
    ds_add_rtn_u32 v31, v27, v2 offset:36864
    s_waitcnt vmcnt(0)
    v_lshrrev_b32 v20, 8, v8
    v_lshl_or_b32 v20, v12, 6, v20
    v_lshl_add_u32 v32, v0, 2, 1
    v_lshl_or_b32 v20, v32, 20, v20
    v_mul_u32_u24 v24, 144, v16
    v_lshrrev_b32 v21, 8, v9
    v_lshl_or_b32 v21, v13, 6, v21
    v_lshl_add_u32 v32, v0, 2, 2
    v_lshl_or_b32 v21, v32, 20, v21
    v_mul_u32_u24 v25, 144, v17
    v_lshrrev_b32 v22, 8, v10
    v_lshl_or_b32 v22, v14, 6, v22
    v_lshl_add_u32 v32, v0, 2, 3
    v_lshl_or_b32 v22, v32, 20, v22
    v_mul_u32_u24 v26, 144, v18
    v_lshrrev_b32 v23, 8, v11
    v_lshl_or_b32 v23, v15, 6, v23
    v_lshl_add_u32 v32, v0, 2, 4
    v_lshl_or_b32 v23, v32, 20, v23
    v_mul_u32_u24 v27, 144, v19
    s_waitcnt lgkmcnt(0)
    v_and_b32 v32, 3, v28
    v_bfe_u32 v33, v28, 2, 2
    v_lshl_add_u32 v32, v32, 2, v33
    v_or_b32 v32, 16, v32
    v_cmp_gt_u32 vcc, 16, v28
    s_nop 1
    v_cndmask_b32 v32, v32, v28, vcc
    v_lshl_add_u32 v24, v32, 2, v24
    v_cmp_gt_u32 vcc, 32, v28
    s_mov_b64 exec, vcc
    ds_write_b32 v24, v20
    s_andn2_b64 exec, s[28:29], vcc
    s_cbranch_execz K1_NOV0
    ds_add_rtn_u32 v33, v3, v2
    v_mov_b32 v34, v20
    v_mov_b32 v35, v16
    s_waitcnt lgkmcnt(0)
    v_lshlrev_b32 v33, 3, v33
    buffer_store_dwordx2 v[34:35], v33, s[24:27], 0 offen sc0 sc1
    s_nop 1
K1_NOV0:
    s_mov_b64 exec, s[28:29]
    v_and_b32 v32, 3, v29
    v_bfe_u32 v33, v29, 2, 2
    v_lshl_add_u32 v32, v32, 2, v33
    v_or_b32 v32, 16, v32
    v_cmp_gt_u32 vcc, 16, v29
    s_nop 1
    v_cndmask_b32 v32, v32, v29, vcc
    v_lshl_add_u32 v25, v32, 2, v25
    v_cmp_gt_u32 vcc, 32, v29
    s_mov_b64 exec, vcc
    ds_write_b32 v25, v21
    s_andn2_b64 exec, s[28:29], vcc
    s_cbranch_execz K1_NOV1
    ds_add_rtn_u32 v33, v3, v2
    v_mov_b32 v34, v21
    v_mov_b32 v35, v17
    s_waitcnt lgkmcnt(0)
    v_lshlrev_b32 v33, 3, v33
    buffer_store_dwordx2 v[34:35], v33, s[24:27], 0 offen sc0 sc1
    s_nop 1
K1_NOV1:
    s_mov_b64 exec, s[28:29]
    v_and_b32 v32, 3, v30
    v_bfe_u32 v33, v30, 2, 2
    v_lshl_add_u32 v32, v32, 2, v33
    v_or_b32 v32, 16, v32
    v_cmp_gt_u32 vcc, 16, v30
    s_nop 1
    v_cndmask_b32 v32, v32, v30, vcc
    v_lshl_add_u32 v26, v32, 2, v26
    v_cmp_gt_u32 vcc, 32, v30
    s_mov_b64 exec, vcc
    ds_write_b32 v26, v22
    s_andn2_b64 exec, s[28:29], vcc
    s_cbranch_execz K1_NOV2
    ds_add_rtn_u32 v33, v3, v2
    v_mov_b32 v34, v22
    v_mov_b32 v35, v18
    s_waitcnt lgkmcnt(0)
    v_lshlrev_b32 v33, 3, v33
    buffer_store_dwordx2 v[34:35], v33, s[24:27], 0 offen sc0 sc1
    s_nop 1
K1_NOV2:
    s_mov_b64 exec, s[28:29]
    v_and_b32 v32, 3, v31
    v_bfe_u32 v33, v31, 2, 2
    v_lshl_add_u32 v32, v32, 2, v33
    v_or_b32 v32, 16, v32
    v_cmp_gt_u32 vcc, 16, v31
    s_nop 1
    v_cndmask_b32 v32, v32, v31, vcc
    v_lshl_add_u32 v27, v32, 2, v27
    v_cmp_gt_u32 vcc, 32, v31
    s_mov_b64 exec, vcc
    ds_write_b32 v27, v23
    s_andn2_b64 exec, s[28:29], vcc
    s_cbranch_execz K1_NOV3
    ds_add_rtn_u32 v33, v3, v2
    v_mov_b32 v34, v23
    v_mov_b32 v35, v19
    s_waitcnt lgkmcnt(0)
    v_lshlrev_b32 v33, 3, v33
    buffer_store_dwordx2 v[34:35], v33, s[24:27], 0 offen sc0 sc1
    s_nop 1
K1_NOV3:
    s_mov_b64 exec, s[28:29]
K1_SKIP:
    s_mov_b64 exec, -1
    s_waitcnt vmcnt(0)
    v_lshrrev_b32 v4, 3, v0
    v_and_b32 v5, 7, v0
    v_lshrrev_b32 v21, 2, v0
    v_and_b32 v23, 3, v0
    v_mul_u32_u24 v6, 144, v21
    v_lshl_add_u32 v6, v23, 4, v6
    v_add_u32 v7, s2, v4
    v_and_b32 v7, 255, v7
    v_lshlrev_b32 v7, 7, v7
    v_lshl_add_u32 v7, v4, 15, v7
    v_lshl_add_u32 v7, v5, 4, v7
    v_lshlrev_b32 v18, 2, v21
    s_mov_b32 s36, 0x400000
    s_waitcnt lgkmcnt(0)
    s_barrier
    ds_read_b128 v[8:11], v6
    ds_read_b32 v19, v18 offset:36864
    ds_read_b128 v[12:15], v6 offset:64
    ds_read_b32 v16, v3
    s_waitcnt lgkmcnt(3)
    buffer_store_dwordx4 v[8:11], v7, s[32:35], 0 offen sc0 sc1
    s_waitcnt lgkmcnt(1)
    v_cmp_le_u32 vcc, 16, v19
    s_mov_b64 exec, vcc
    buffer_store_dwordx4 v[12:15], v7, s[32:35], s36 offen sc0 sc1
    s_mov_b64 exec, -1
    v_cmp_le_u32 vcc, 32, v19
    s_cbranch_vccz K1_END
    s_lshl_b32 s10, s2, 2
    s_waitcnt lgkmcnt(0)
    s_mov_b64 exec, 1
    v_mov_b32 v17, s10
    buffer_store_dword v16, v17, s[40:43], 0 offen sc0 sc1
    s_branch K1_END
K1_W:
    s_load_dwordx8 s[12:19], s[0:1], 32
    s_load_dwordx2 s[20:21], s[0:1], 64
    v_lshrrev_b32 v1, 6, v0
    s_nop 0
    v_readfirstlane_b32 s10, v1
    s_lshl_b32 s11, s2, 4
    s_nop 2
    s_add_u32 s10, s10, s11
    s_cmp_ge_u32 s10, 34
    s_cbranch_scc1 K1_END
    s_waitcnt lgkmcnt(0)
    s_mov_b32 s24, s14
    s_mov_b32 s25, s15
    s_mov_b32 s26, 8192
    s_mov_b32 s27, 0x20000
    s_mov_b32 s28, 0xbfb8aa3b
    s_mov_b32 s29, s10
    s_cmp_ge_u32 s10, 8
    s_cbranch_scc0 K1_WSEL
    s_mov_b32 s24, s20
    s_mov_b32 s25, s21
    s_mov_b32 s28, 0x3f800000
    s_sub_u32 s29, s10, 8
    s_cmp_ge_u32 s10, 16
    s_cbranch_scc0 K1_WSEL
    s_mov_b32 s24, s16
    s_mov_b32 s25, s17
    s_mov_b32 s26, 2048
    s_mov_b32 s28, 0xbfb8aa3b
    s_sub_u32 s29, s10, 16
    s_lshl_b32 s29, s29, 2
    s_cmp_ge_u32 s10, 18
    s_cbranch_scc0 K1_WSEL
    s_mov_b32 s24, s12
    s_mov_b32 s25, s13
    s_mov_b32 s26, 8192
    s_mov_b32 s28, 0x3f800000
    s_sub_u32 s29, s10, 18
    s_cmp_ge_u32 s10, 26
    s_cbranch_scc0 K1_WSEL
    s_mov_b32 s24, s18
    s_mov_b32 s25, s19
    s_sub_u32 s29, s10, 26
K1_WSEL:
    s_lshr_b32 s30, s29, 2
    s_and_b32 s31, s29, 3
    s_lshl_b32 s30, s30, 6
    s_lshl_b32 s31, s31, 11
    s_add_u32 s30, s30, s31
    v_and_b32 v2, 63, v0
    v_and_b32 v3, 31, v0
    v_lshrrev_b32 v4, 5, v2
    v_lshlrev_b32 v4, 10, v4
    v_lshl_add_u32 v4, v3, 1, v4
    v_add_u32 v4, s30, v4
    buffer_load_ushort v8, v4, s[24:27], 0 offen offset:0 nt
    buffer_load_ushort v9, v4, s[24:27], 0 offen offset:128 nt
    buffer_load_ushort v10, v4, s[24:27], 0 offen offset:256 nt
    buffer_load_ushort v11, v4, s[24:27], 0 offen offset:384 nt
    buffer_load_ushort v12, v4, s[24:27], 0 offen offset:512 nt
    buffer_load_ushort v13, v4, s[24:27], 0 offen offset:640 nt
    buffer_load_ushort v14, v4, s[24:27], 0 offen offset:768 nt
    buffer_load_ushort v15, v4, s[24:27], 0 offen offset:896 nt
    s_add_u32 s32, s8, 8392704
    s_addc_u32 s33, s9, 0
    s_mov_b32 s34, 34816
    s_mov_b32 s35, 0x20000
    s_lshl_b32 s36, s10, 10
    v_lshlrev_b32 v5, 4, v2
    s_waitcnt vmcnt(0)
    v_lshlrev_b32 v8, 16, v8
    v_mul_f32 v8, s28, v8
    v_lshlrev_b32 v9, 16, v9
    v_mul_f32 v9, s28, v9
    v_lshlrev_b32 v10, 16, v10
    v_mul_f32 v10, s28, v10
    v_lshlrev_b32 v11, 16, v11
    v_mul_f32 v11, s28, v11
    v_lshlrev_b32 v12, 16, v12
    v_mul_f32 v12, s28, v12
    v_lshlrev_b32 v13, 16, v13
    v_mul_f32 v13, s28, v13
    v_lshlrev_b32 v14, 16, v14
    v_mul_f32 v14, s28, v14
    v_lshlrev_b32 v15, 16, v15
    v_mul_f32 v15, s28, v15
    v_cvt_pk_bf16_f32 v16, v8, v9
    v_cvt_pk_bf16_f32 v17, v10, v11
    v_cvt_pk_bf16_f32 v18, v12, v13
    v_cvt_pk_bf16_f32 v19, v14, v15
    buffer_store_dwordx4 v[16:19], v5, s[32:35], s36 offen sc0 sc1
K1_END:
    s_endpgm
.globl standalone__edge_featured_mpnn_gatedgcn__graph_kernel
.p2align 8
.type standalone__edge_featured_mpnn_gatedgcn__graph_kernel,@function
standalone__edge_featured_mpnn_gatedgcn__graph_kernel:
    s_cmp_ge_u32 s2, 256
    s_cbranch_scc1 K2_END
    s_load_dwordx2 s[28:29], s[0:1], 88
    s_load_dwordx4 s[4:7], s[0:1], 0
    s_load_dwordx2 s[20:21], s[0:1], 72
    s_and_b32 s3, s2, 7
    s_lshl_b32 s3, s3, 5
    s_lshr_b32 s75, s2, 3
    s_or_b32 s3, s3, s75
    v_lshrrev_b32 v1, 6, v0
    v_and_b32 v15, 63, v0
    v_readfirstlane_b32 s30, v1
    v_lshlrev_b32 v228, 4, v15
    s_lshr_b32 s82, s3, 1
    s_and_b32 s35, s3, 1
    s_lshl_b32 s35, s35, 6
    v_lshrrev_b32 v4, 2, v0
    v_and_b32 v5, 3, v0
    v_add_u32 v198, s82, v4
    v_and_b32 v198, 255, v198
    v_lshlrev_b32 v198, 7, v198
    v_lshl_add_u32 v198, v5, 4, v198
    v_add_u32 v198, s35, v198
    v_cmp_gt_u32 vcc, 250, v4
    v_mov_b32 v14, 0x7fffffff
    s_nop 0
    v_cndmask_b32 v198, v14, v198, vcc
    v_add_u32 v4, 128, v4
    v_add_u32 v199, s82, v4
    v_and_b32 v199, 255, v199
    v_lshlrev_b32 v199, 7, v199
    v_lshl_add_u32 v199, v5, 4, v199
    v_add_u32 v199, s35, v199
    v_cmp_gt_u32 vcc, 250, v4
    v_mov_b32 v14, 0x7fffffff
    s_nop 0
    v_cndmask_b32 v199, v14, v199, vcc
    s_lshl_b32 s75, s82, 15
    s_waitcnt lgkmcnt(0)
    s_add_u32 s12, s28, s75
    s_addc_u32 s13, s29, 0
    s_mov_b32 s14, 4227072
    s_mov_b32 s15, 0x20000
    buffer_load_dwordx4 v[136:139], v198, s[12:15], 0 offen
    buffer_load_dwordx4 v[140:143], v199, s[12:15], 0 offen
    s_mov_b32 s81, 0x400000
    v_lshlrev_b32 v1, 4, v0
    v_mov_b32 v112, -1
    v_mov_b32 v113, -1
    v_mov_b32 v114, -1
    v_mov_b32 v115, -1
    v_add_u32 v14, 135936, v1
    ds_write_b128 v14, v[112:115]
    v_mov_b32 v116, 0x700fffff
    v_mov_b32 v117, 0x700fffff
    v_mov_b32 v118, 0x700fffff
    v_mov_b32 v119, 0x700fffff
    ds_write_b128 v14, v[116:119] offset:8192
    ds_write_b128 v14, v[116:119] offset:16384
    v_mov_b32 v120, 0x04360436
    v_mov_b32 v121, 0x04360436
    v_mov_b32 v122, 0x04360436
    v_mov_b32 v123, 0x04360436
    v_mov_b32 v124, 0
    v_mov_b32 v125, 0
    v_mov_b32 v126, 0
    v_mov_b32 v127, 0
    v_cmp_gt_u32 vcc, 64, v0
    s_nop 1
    v_cndmask_b32 v120, v124, v120, vcc
    v_cndmask_b32 v121, v125, v121, vcc
    v_cndmask_b32 v122, v126, v122, vcc
    v_cndmask_b32 v123, v127, v123, vcc
    v_cmp_gt_u32 vcc, 96, v0
    s_and_saveexec_b64 s[40:41], vcc
    ds_write_b128 v14, v[120:123] offset:24576
    s_mov_b64 exec, s[40:41]
    s_mov_b32 s8, s6
    s_mov_b32 s9, s7
    s_mov_b32 s10, 25600000
    s_mov_b32 s11, 0x20000
    s_mov_b32 s6, 1600000
    s_mov_b32 s7, 0x20000
    s_mov_b32 s22, 1600000
    s_mov_b32 s23, 0x20000
    s_add_u32 s16, s28, 8392704
    s_addc_u32 s17, s29, 0
    s_mov_b32 s18, 34816
    s_mov_b32 s19, 0x20000
    v_lshrrev_b32 v14, 3, v15
    s_lshl_b32 s75, s30, 3
    v_add_u32 v14, s75, v14
    v_lshlrev_b32 v14, 8, v14
    v_add_u32 v14, s3, v14
    v_lshlrev_b32 v14, 7, v14
    v_lshrrev_b32 v4, 4, v15
    v_and_b32 v5, 7, v15
    v_xor_b32 v4, v4, v5
    v_lshlrev_b32 v2, 4, v4
    v_xor_b32 v3, 64, v2
    s_and_b32 s75, s30, 1
    s_cmp_eq_u32 s75, 0
    s_cselect_b64 vcc, -1, 0
    v_cndmask_b32 v4, v3, v2, vcc
    v_add_u32 v4, v14, v4
    v_mov_b32 v202, v4
    v_lshrrev_b32 v14, 6, v0
    v_mul_u32_u24 v14, 1408, v14
    v_add_u32 v14, v14, v228
    v_add_u32 v14, 65792, v14
    v_mov_b32 v112, 0
    v_mov_b32 v113, 0
    v_mov_b32 v114, 0
    v_mov_b32 v115, 0
    ds_write_b128 v14, v[112:115] offset:0
    ds_write_b128 v14, v[112:115] offset:11264
    ds_write_b128 v14, v[112:115] offset:22528
    ds_write_b128 v14, v[112:115] offset:33792
    ds_write_b128 v14, v[112:115] offset:45056
    v_add_u32 v14, 56320, v14
    ds_write_b128 v14, v[112:115]
    v_cmp_gt_u32 vcc, 128, v0
    s_and_saveexec_b64 s[40:41], vcc
    ds_write_b128 v14, v[112:115] offset:11264
    s_mov_b64 exec, s[40:41]
    v_mov_b32 v220, 1
    v_mov_b32 v230, 162048
    ds_write_b32 v230, v112
    s_mov_b32 s72, 161536
    s_mov_b32 s73, 135936
    s_mov_b32 s74, 144128
    s_mov_b32 s83, 128
    s_mov_b32 s36, 0
    s_mov_b32 s37, 1
    s_mov_b32 s39, 0
    s_lshr_b32 s95, s30, 2
    v_lshrrev_b32 v4, 2, v0
    v_mul_u32_u24 v4, 3200, v4
    v_add_u32 v168, 0x3fffffff, v4
    v_add_u32 v169, 0x40063fff, v4
    v_add_u32 v170, 0x3fffffff, v4
    v_add_u32 v171, 0x40063fff, v4
    v_mov_b32 v144, 0
    v_mov_b32 v145, 0
    v_mov_b32 v146, 0
    v_mov_b32 v147, 0
    v_mov_b32 v148, 0
    v_mov_b32 v149, 0
    v_mov_b32 v150, 0
    v_mov_b32 v151, 0
    v_lshrrev_b32 v1, 5, v15
    v_lshlrev_b32 v6, 4, v1
    v_bfe_u32 v5, v15, 3, 2
    v_lshlrev_b32 v4, 5, v1
    v_lshl_add_u32 v4, v5, 2, v4
    v_add_u32 v221, 135936, v4
    v_bfe_u32 v4, v15, 2, 1
    v_lshlrev_b32 v4, 4, v4
    v_bfe_u32 v5, v15, 4, 1
    v_lshl_add_u32 v4, v5, 3, v4
    v_and_b32 v5, 3, v15
    v_lshl_add_u32 v4, v5, 1, v4
    v_bfe_u32 v5, v15, 3, 1
    v_add_u32 v4, v4, v5
    v_lshlrev_b32 v4, 2, v4
    v_add_u32 v222, 144128, v4
    v_lshlrev_b32 v4, 2, v1
    v_add_u32 v223, 160512, v4
    v_and_b32 v4, 31, v15
    v_lshlrev_b32 v5, 2, v4
    v_add_u32 v8, 65536, v5
    v_lshlrev_b32 v5, 3, v4
    v_add_u32 v9, 65792, v5
    v_bfe_u32 v5, v15, 1, 3
    v_xor_b32 v5, v5, v1
    v_lshlrev_b32 v5, 4, v5
    v_lshl_add_u32 v4, v4, 7, v5
    v_xor_b32 v224, 0, v4
    v_xor_b32 v225, 32, v4
    v_xor_b32 v226, 64, v4
    v_xor_b32 v227, 96, v4
    s_lshl_b32 s33, s30, 12
    s_add_u32 s34, s33, 32768
    v_add_u32 v252, 4096, v2
    v_add_u32 v253, 3072, v3
    v_add_u32 v254, 2048, v2
    v_add_u32 v255, 1024, v3
    v_bfe_u32 v4, v15, 2, 1
    v_cmp_eq_u32 vcc, v4, v1
    v_mov_b32 v5, 0x3f803f80
    s_nop 0
    v_cndmask_b32 v5, 0, v5, vcc
    v_bfe_u32 v4, v15, 4, 1
    v_cmp_eq_u32 vcc, 0, v4
    s_nop 1
    v_cndmask_b32 v92, 0, v5, vcc
    v_sub_u32 v94, v5, v92
    v_mov_b32 v93, 0
    v_mov_b32 v95, 0
    v_mov_b32 v96, 0
    v_mov_b32 v97, v92
    v_mov_b32 v98, 0
    v_mov_b32 v99, v94
    v_cmp_eq_u32 vcc, 0, v1
    v_mov_b32 v5, 0x3f000000
    s_nop 0
    v_cndmask_b32 v100, 0, v5, vcc
    v_mov_b32 v101, 0
    v_mov_b32 v105, 0
    v_mov_b32 v109, 0
    v_mov_b32 v102, 0
    v_mov_b32 v106, 0
    v_mov_b32 v110, 0
    v_mov_b32 v103, 0
    v_mov_b32 v107, 0
    v_mov_b32 v111, 0
    s_waitcnt vmcnt(0)
    v_mov_b32_dpp v14, v139 quad_perm:[3,3,3,3] row_mask:0xf bank_mask:0xf
    s_nop 0
    v_cmp_ne_u32 vcc, 0, v14
    s_mov_b64 exec, vcc
    buffer_load_dwordx4 v[144:147], v198, s[12:15], s81 offen
    s_mov_b64 exec, -1
    v_mov_b32_dpp v14, v143 quad_perm:[3,3,3,3] row_mask:0xf bank_mask:0xf
    s_nop 0
    v_cmp_ne_u32 vcc, 0, v14
    s_mov_b64 exec, vcc
    buffer_load_dwordx4 v[148:151], v199, s[12:15], s81 offen
    s_mov_b64 exec, -1
    s_lshl_b32 s75, s30, 10
    s_add_u32 m0, s75, 32768
    s_nop 0
    buffer_load_dwordx4 v202, s[4:7], 0 offen lds
    s_add_u32 s76, s75, 0
    s_add_u32 m0, s76, 40960
    s_nop 0
    buffer_load_dwordx4 v228, s[16:19], s76 offen lds
    s_add_u32 s76, s75, 8192
    s_add_u32 m0, s76, 40960
    s_nop 0
    buffer_load_dwordx4 v228, s[16:19], s76 offen lds
    s_add_u32 s76, s75, 16384
    s_add_u32 m0, s76, 40960
    s_nop 0
    buffer_load_dwordx4 v228, s[16:19], s76 offen lds
    s_branch K2_WD
K2_ROUND:
    v_lshlrev_b32 v1, 4, v0
    v_mov_b32 v112, -1
    v_mov_b32 v113, -1
    v_mov_b32 v114, -1
    v_mov_b32 v115, -1
    v_add_u32 v14, 135936, v1
    ds_write_b128 v14, v[112:115]
    v_mov_b32 v116, 0x700fffff
    v_mov_b32 v117, 0x700fffff
    v_mov_b32 v118, 0x700fffff
    v_mov_b32 v119, 0x700fffff
    ds_write_b128 v14, v[116:119] offset:8192
    ds_write_b128 v14, v[116:119] offset:16384
    v_mov_b32 v120, 0x04360436
    v_mov_b32 v121, 0x04360436
    v_mov_b32 v122, 0x04360436
    v_mov_b32 v123, 0x04360436
    v_mov_b32 v124, 0
    v_mov_b32 v125, 0
    v_mov_b32 v126, 0
    v_mov_b32 v127, 0
    v_cmp_gt_u32 vcc, 64, v0
    s_nop 1
    v_cndmask_b32 v120, v124, v120, vcc
    v_cndmask_b32 v121, v125, v121, vcc
    v_cndmask_b32 v122, v126, v122, vcc
    v_cndmask_b32 v123, v127, v123, vcc
    v_cmp_gt_u32 vcc, 96, v0
    s_and_saveexec_b64 s[40:41], vcc
    ds_write_b128 v14, v[120:123] offset:24576
    s_mov_b64 exec, s[40:41]
    s_waitcnt vmcnt(0)
K2_WD:
    v_cmp_ne_u32 s[40:41], 0, v136
    v_cmp_ne_u32 s[42:43], 0, v137
    v_cmp_ne_u32 s[44:45], 0, v138
    v_cmp_ne_u32 s[46:47], 0, v139
    v_cmp_ne_u32 s[48:49], 0, v140
    v_cmp_ne_u32 s[50:51], 0, v141
    v_cmp_ne_u32 s[52:53], 0, v142
    v_cmp_ne_u32 s[54:55], 0, v143
    v_and_b32 v172, 63, v136
    v_lshl_add_u32 v172, v172, 2, s72
    v_and_b32 v173, 63, v137
    v_lshl_add_u32 v173, v173, 2, s72
    v_and_b32 v174, 63, v138
    v_lshl_add_u32 v174, v174, 2, s72
    v_and_b32 v175, 63, v139
    v_lshl_add_u32 v175, v175, 2, s72
    v_and_b32 v176, 63, v140
    v_lshl_add_u32 v176, v176, 2, s72
    v_and_b32 v177, 63, v141
    v_lshl_add_u32 v177, v177, 2, s72
    v_and_b32 v178, 63, v142
    v_lshl_add_u32 v178, v178, 2, s72
    v_and_b32 v179, 63, v143
    v_lshl_add_u32 v179, v179, 2, s72
    s_waitcnt lgkmcnt(0)
    s_barrier
    s_mov_b64 exec, s[40:41]
    ds_add_rtn_u32 v152, v172, v220
    s_mov_b64 exec, s[42:43]
    ds_add_rtn_u32 v153, v173, v220
    s_mov_b64 exec, s[44:45]
    ds_add_rtn_u32 v154, v174, v220
    s_mov_b64 exec, s[46:47]
    ds_add_rtn_u32 v155, v175, v220
    s_mov_b64 exec, s[48:49]
    ds_add_rtn_u32 v156, v176, v220
    s_mov_b64 exec, s[50:51]
    ds_add_rtn_u32 v157, v177, v220
    s_mov_b64 exec, s[52:53]
    ds_add_rtn_u32 v158, v178, v220
    s_mov_b64 exec, s[54:55]
    ds_add_rtn_u32 v159, v179, v220
    s_mov_b64 exec, -1
    s_cmp_eq_u32 s37, 1
    s_cbranch_scc0 K2_NF1
    s_lshr_b32 s75, s30, 1
    s_lshl_b32 s75, s75, 12
    s_add_u32 s75, s75, 18432
    buffer_load_dwordx4 v[236:239], v228, s[16:19], s75 offen offset:0
    buffer_load_dwordx4 v[240:243], v228, s[16:19], s75 offen offset:1024
    buffer_load_dwordx4 v[244:247], v228, s[16:19], s75 offen offset:2048
    buffer_load_dwordx4 v[248:251], v228, s[16:19], s75 offen offset:3072
    s_lshr_b32 s75, s2, 3
    s_mul_i32 s75, s75, 391
    v_add_u32 v14, s75, v0
    v_lshlrev_b32 v14, 7, v14
    v_cmp_gt_u32 vcc, 391, v0
    v_mov_b32 v235, 0x7fffffff
    s_nop 0
    v_cndmask_b32 v14, v235, v14, vcc
    v_mov_b32 v229, v14
    s_cmp_ge_u32 s30, 4
    s_cselect_b64 vcc, -1, 0
    v_cndmask_b32 v14, v14, v235, vcc
    v_cndmask_b32 v229, v235, v229, vcc
    v_mov_b32 v199, v14
K2_NF1:
    v_lshrrev_b32 v112, 20, v136
    v_bfe_u32 v136, v136, 6, 14
    v_add_u32 v112, v112, v168
    v_lshrrev_b32 v113, 20, v137
    v_bfe_u32 v137, v137, 6, 14
    v_add_u32 v113, v113, v168
    v_lshrrev_b32 v114, 20, v138
    v_bfe_u32 v138, v138, 6, 14
    v_add_u32 v114, v114, v168
    v_lshrrev_b32 v115, 20, v139
    v_bfe_u32 v139, v139, 6, 14
    v_add_u32 v115, v115, v168
    v_lshrrev_b32 v116, 20, v140
    v_bfe_u32 v140, v140, 6, 14
    v_add_u32 v116, v116, v169
    v_lshrrev_b32 v117, 20, v141
    v_bfe_u32 v141, v141, 6, 14
    v_add_u32 v117, v117, v169
    v_lshrrev_b32 v118, 20, v142
    v_bfe_u32 v142, v142, 6, 14
    v_add_u32 v118, v118, v169
    v_lshrrev_b32 v119, 20, v143
    v_bfe_u32 v143, v143, 6, 14
    v_add_u32 v119, v119, v169
    s_waitcnt vmcnt(8)
    v_cmp_ne_u32 s[56:57], 0, v144
    v_cmp_ne_u32 s[58:59], 0, v145
    v_cmp_ne_u32 s[60:61], 0, v146
    v_cmp_ne_u32 s[62:63], 0, v147
    v_cmp_ne_u32 s[64:65], 0, v148
    v_cmp_ne_u32 s[66:67], 0, v149
    v_cmp_ne_u32 s[68:69], 0, v150
    v_cmp_ne_u32 s[70:71], 0, v151
    v_and_b32 v180, 63, v144
    v_lshl_add_u32 v180, v180, 2, s72
    v_and_b32 v184, 63, v148
    v_lshl_add_u32 v184, v184, 2, s72
    s_mov_b64 exec, s[56:57]
    ds_add_rtn_u32 v160, v180, v220
    s_mov_b64 exec, s[64:65]
    ds_add_rtn_u32 v164, v184, v220
    s_mov_b64 exec, -1
    v_lshrrev_b32 v120, 20, v144
    v_bfe_u32 v144, v144, 6, 14
    v_add_u32 v120, v120, v170
    v_lshrrev_b32 v124, 20, v148
    v_bfe_u32 v148, v148, 6, 14
    v_add_u32 v124, v124, v171
    s_or_b64 s[84:85], s[58:59], s[66:67]
    s_cselect_b32 s76, 1, 0
    s_or_b64 s[84:85], s[60:61], s[62:63]
    s_or_b64 s[84:85], s[84:85], s[68:69]
    s_or_b64 s[84:85], s[84:85], s[70:71]
    s_cselect_b32 s77, 1, 0
    s_cmp_eq_u32 s76, 0
    s_cbranch_scc1 K2_SKH0
    v_and_b32 v181, 63, v145
    v_lshl_add_u32 v181, v181, 2, s72
    v_and_b32 v185, 63, v149
    v_lshl_add_u32 v185, v185, 2, s72
    s_mov_b64 exec, s[58:59]
    ds_add_rtn_u32 v161, v181, v220
    s_mov_b64 exec, s[66:67]
    ds_add_rtn_u32 v165, v185, v220
    s_mov_b64 exec, -1
    v_lshrrev_b32 v121, 20, v145
    v_bfe_u32 v145, v145, 6, 14
    v_add_u32 v121, v121, v170
    v_lshrrev_b32 v125, 20, v149
    v_bfe_u32 v149, v149, 6, 14
    v_add_u32 v125, v125, v171
K2_SKH0:
    s_cmp_eq_u32 s77, 0
    s_cbranch_scc1 K2_SKH1
    v_and_b32 v182, 63, v146
    v_lshl_add_u32 v182, v182, 2, s72
    v_and_b32 v183, 63, v147
    v_lshl_add_u32 v183, v183, 2, s72
    v_and_b32 v186, 63, v150
    v_lshl_add_u32 v186, v186, 2, s72
    v_and_b32 v187, 63, v151
    v_lshl_add_u32 v187, v187, 2, s72
    s_mov_b64 exec, s[60:61]
    ds_add_rtn_u32 v162, v182, v220
    s_mov_b64 exec, s[62:63]
    ds_add_rtn_u32 v163, v183, v220
    s_mov_b64 exec, s[68:69]
    ds_add_rtn_u32 v166, v186, v220
    s_mov_b64 exec, s[70:71]
    ds_add_rtn_u32 v167, v187, v220
    s_mov_b64 exec, -1
    v_lshrrev_b32 v122, 20, v146
    v_bfe_u32 v146, v146, 6, 14
    v_add_u32 v122, v122, v170
    v_lshrrev_b32 v123, 20, v147
    v_bfe_u32 v147, v147, 6, 14
    v_add_u32 v123, v123, v170
    v_lshrrev_b32 v126, 20, v150
    v_bfe_u32 v150, v150, 6, 14
    v_add_u32 v126, v126, v171
    v_lshrrev_b32 v127, 20, v151
    v_bfe_u32 v151, v151, 6, 14
    v_add_u32 v127, v127, v171
    s_mov_b32 s84, 0x88888888
    s_mov_b32 s85, 0x88888888
    s_and_b64 exec, s[62:63], s[84:85]
    s_cbranch_execz K2_NFULL0
    ds_add_rtn_u32 v14, v230, v220
    v_lshrrev_b32 v1, 2, v0
    v_add_u32 v1, 0, v1
    s_waitcnt lgkmcnt(0)
    v_lshlrev_b32 v14, 1, v14
    v_add_u32 v14, 162052, v14
    ds_write_b16 v14, v1
K2_NFULL0:
    s_mov_b64 exec, -1
    s_and_b64 exec, s[70:71], s[84:85]
    s_cbranch_execz K2_NFULL1
    ds_add_rtn_u32 v14, v230, v220
    v_lshrrev_b32 v1, 2, v0
    v_add_u32 v1, 128, v1
    s_waitcnt lgkmcnt(0)
    v_lshlrev_b32 v14, 1, v14
    v_add_u32 v14, 162052, v14
    ds_write_b16 v14, v1
K2_NFULL1:
    s_mov_b64 exec, -1
K2_SKH1:
    s_waitcnt lgkmcnt(0)
    s_barrier
    s_cmp_eq_u32 s37, 1
    s_cbranch_scc0 K2_NF2
    buffer_load_dword v235, v199, s[4:7], 0 offen
K2_NF2:
    v_lshl_add_u32 v4, v15, 2, s72
    ds_read_b32 v5, v4
    ds_read_b32 v14, v230
    s_waitcnt lgkmcnt(0)
    v_readfirstlane_b32 s38, v14
    v_add_u32 v5, 7, v5
    v_lshrrev_b32 v5, 3, v5
    v_mov_b32 v1, v5
    s_nop 1
    v_add_u32_dpp v1, v1, v1 row_shr:1 row_mask:0xf bank_mask:0xf bound_ctrl:0
    s_nop 1
    v_add_u32_dpp v1, v1, v1 row_shr:2 row_mask:0xf bank_mask:0xf bound_ctrl:0
    s_nop 1
    v_add_u32_dpp v1, v1, v1 row_shr:4 row_mask:0xf bank_mask:0xf bound_ctrl:0
    s_nop 1
    v_add_u32_dpp v1, v1, v1 row_shr:8 row_mask:0xf bank_mask:0xf bound_ctrl:0
    s_nop 1
    v_add_u32_dpp v1, v1, v1 row_bcast:15 row_mask:0xa bank_mask:0xf
    s_nop 1
    v_add_u32_dpp v1, v1, v1 row_bcast:31 row_mask:0xc bank_mask:0xf
    s_nop 1
    v_readlane_b32 s31, v1, 63
    v_sub_u32 v1, v1, v5
    v_lshlrev_b32 v234, 3, v1
    ds_write_b32 v4, v234 offset:256
    s_cmp_gt_u32 s31, 512
    s_cbranch_scc1 K2_SPLIT
    ds_read_b32 v172, v172 offset:256
    ds_read_b32 v173, v173 offset:256
    ds_read_b32 v174, v174 offset:256
    ds_read_b32 v175, v175 offset:256
    ds_read_b32 v176, v176 offset:256
    ds_read_b32 v177, v177 offset:256
    ds_read_b32 v178, v178 offset:256
    ds_read_b32 v179, v179 offset:256
    ds_read_b32 v180, v180 offset:256
    ds_read_b32 v184, v184 offset:256
    s_cmp_eq_u32 s76, 0
    s_cbranch_scc1 K2_SKN0
    ds_read_b32 v181, v181 offset:256
    ds_read_b32 v185, v185 offset:256
K2_SKN0:
    s_cmp_eq_u32 s77, 0
    s_cbranch_scc1 K2_SKN1
    ds_read_b32 v182, v182 offset:256
    ds_read_b32 v183, v183 offset:256
    ds_read_b32 v186, v186 offset:256
    ds_read_b32 v187, v187 offset:256
K2_SKN1:
    v_mul_u32_u24 v202, 22, v15
    v_mov_b32 v203, s30
K2_GL:
    v_cmp_lt_u32 vcc, v203, v5
    s_and_saveexec_b64 s[84:85], vcc
    s_cbranch_execz K2_GLD
    v_add_u32 v204, v1, v203
    v_lshlrev_b32 v204, 1, v204
    v_add_u32 v204, 160512, v204
    ds_write_b16 v204, v202
    v_add_u32 v203, 8, v203
    s_mov_b64 exec, s[84:85]
    s_branch K2_GL
K2_GLD:
    s_mov_b64 exec, -1
    s_cmp_eq_u32 s37, 1
    s_cbranch_scc0 K2_NF3
    buffer_load_dword v235, v229, s[4:7], 0 offen
K2_NF3:
    s_waitcnt lgkmcnt(0)
    v_add_u32 v152, v152, v172
    v_lshl_add_u32 v172, v152, 1, s73
    v_lshl_add_u32 v152, v152, 2, s74
    v_add_u32 v153, v153, v173
    v_lshl_add_u32 v173, v153, 1, s73
    v_lshl_add_u32 v153, v153, 2, s74
    v_add_u32 v154, v154, v174
    v_lshl_add_u32 v174, v154, 1, s73
    v_lshl_add_u32 v154, v154, 2, s74
    v_add_u32 v155, v155, v175
    v_lshl_add_u32 v175, v155, 1, s73
    v_lshl_add_u32 v155, v155, 2, s74
    v_add_u32 v156, v156, v176
    v_lshl_add_u32 v176, v156, 1, s73
    v_lshl_add_u32 v156, v156, 2, s74
    v_add_u32 v157, v157, v177
    v_lshl_add_u32 v177, v157, 1, s73
    v_lshl_add_u32 v157, v157, 2, s74
    v_add_u32 v158, v158, v178
    v_lshl_add_u32 v178, v158, 1, s73
    v_lshl_add_u32 v158, v158, 2, s74
    v_add_u32 v159, v159, v179
    v_lshl_add_u32 v179, v159, 1, s73
    v_lshl_add_u32 v159, v159, 2, s74
    v_add_u32 v160, v160, v180
    v_lshl_add_u32 v180, v160, 1, s73
    v_lshl_add_u32 v160, v160, 2, s74
    v_add_u32 v164, v164, v184
    v_lshl_add_u32 v184, v164, 1, s73
    v_lshl_add_u32 v164, v164, 2, s74
    s_mov_b64 exec, s[40:41]
    ds_write_b16 v172, v136
    ds_write_b32 v152, v112
    s_mov_b64 exec, s[42:43]
    ds_write_b16 v173, v137
    ds_write_b32 v153, v113
    s_mov_b64 exec, s[44:45]
    ds_write_b16 v174, v138
    ds_write_b32 v154, v114
    s_mov_b64 exec, s[46:47]
    ds_write_b16 v175, v139
    ds_write_b32 v155, v115
    s_mov_b64 exec, s[48:49]
    ds_write_b16 v176, v140
    ds_write_b32 v156, v116
    s_mov_b64 exec, s[50:51]
    ds_write_b16 v177, v141
    ds_write_b32 v157, v117
    s_mov_b64 exec, s[52:53]
    ds_write_b16 v178, v142
    ds_write_b32 v158, v118
    s_mov_b64 exec, s[54:55]
    ds_write_b16 v179, v143
    ds_write_b32 v159, v119
    s_mov_b64 exec, s[56:57]
    ds_write_b16 v180, v144
    ds_write_b32 v160, v120
    s_mov_b64 exec, s[64:65]
    ds_write_b16 v184, v148
    ds_write_b32 v164, v124
    s_mov_b64 exec, -1
    s_cmp_eq_u32 s76, 0
    s_cbranch_scc1 K2_SKS0
    v_add_u32 v161, v161, v181
    v_lshl_add_u32 v181, v161, 1, s73
    v_lshl_add_u32 v161, v161, 2, s74
    v_add_u32 v165, v165, v185
    v_lshl_add_u32 v185, v165, 1, s73
    v_lshl_add_u32 v165, v165, 2, s74
    s_mov_b64 exec, s[58:59]
    ds_write_b16 v181, v145
    ds_write_b32 v161, v121
    s_mov_b64 exec, s[66:67]
    ds_write_b16 v185, v149
    ds_write_b32 v165, v125
    s_mov_b64 exec, -1
K2_SKS0:
    s_cmp_eq_u32 s77, 0
    s_cbranch_scc1 K2_SKS1
    v_add_u32 v162, v162, v182
    v_lshl_add_u32 v182, v162, 1, s73
    v_lshl_add_u32 v162, v162, 2, s74
    v_add_u32 v163, v163, v183
    v_lshl_add_u32 v183, v163, 1, s73
    v_lshl_add_u32 v163, v163, 2, s74
    v_add_u32 v166, v166, v186
    v_lshl_add_u32 v186, v166, 1, s73
    v_lshl_add_u32 v166, v166, 2, s74
    v_add_u32 v167, v167, v187
    v_lshl_add_u32 v187, v167, 1, s73
    v_lshl_add_u32 v167, v167, 2, s74
    s_mov_b64 exec, s[60:61]
    ds_write_b16 v182, v146
    ds_write_b32 v162, v122
    s_mov_b64 exec, s[62:63]
    ds_write_b16 v183, v147
    ds_write_b32 v163, v123
    s_mov_b64 exec, s[68:69]
    ds_write_b16 v186, v150
    ds_write_b32 v166, v126
    s_mov_b64 exec, s[70:71]
    ds_write_b16 v187, v151
    ds_write_b32 v167, v127
    s_mov_b64 exec, -1
K2_SKS1:
    s_add_u32 s31, s31, 3
    s_lshr_b32 s31, s31, 2
    s_waitcnt vmcnt(2) lgkmcnt(0)
    s_barrier
    s_sub_u32 s64, s4, 4096
    s_subb_u32 s65, s5, 0
    s_mov_b32 s66, 1604096
    s_mov_b32 s67, 0x20000
    s_mov_b32 s32, s30
    s_lshl_b32 s75, s30, 6
    v_add_u32 v4, s75, v221
    s_lshl_b32 s75, s30, 7
    v_add_u32 v5, s75, v222
    s_lshl_b32 s75, s30, 3
    v_add_u32 v7, s75, v223
    ds_read_b32 v206, v5
    ds_read2_b32 v[200:201], v4 offset0:0 offset1:4
    ds_read_b32 v208, v7
    v_add_u32 v10, s33, v224
    v_add_u32 v11, s33, v225
    v_add_u32 v12, s33, v226
    v_add_u32 v13, s33, v227
    s_waitcnt lgkmcnt(0)
    s_mov_b32 m0, s33
    v_mad_u32_u16 v202, v200, s83, v252 op_sel:[0,0,0,0]
    buffer_load_dwordx4 v202, s[64:67], 0 offen offset:0 lds
    v_mad_u32_u16 v203, v200, s83, v253 op_sel:[1,0,0,0]
    buffer_load_dwordx4 v203, s[64:67], 0 offen offset:1024 lds
    v_mad_u32_u16 v204, v201, s83, v254 op_sel:[0,0,0,0]
    buffer_load_dwordx4 v204, s[64:67], 0 offen offset:2048 lds
    v_mad_u32_u16 v205, v201, s83, v255 op_sel:[1,0,0,0]
    buffer_load_dwordx4 v205, s[64:67], 0 offen offset:3072 lds
    v_mad_u32_u24 v207, v206, 32, v6
    buffer_load_dwordx4 v[128:131], v207, s[8:11], 0 offen nt
    v_and_b32 v104, 0xff000000, v206
    s_cmp_eq_u32 s37, 0
    s_cbranch_scc1 K2_NG_DONE
    v_add_u32 v1, 40960, v228
    s_and_b32 s75, s30, 1
    s_lshl_b32 s75, s75, 12
    s_add_u32 s75, s75, 32768
    v_add_u32 v202, s75, v224
    v_add_u32 v203, s75, v225
    v_add_u32 v204, s75, v226
    v_add_u32 v205, s75, v227
    ds_read_b128 v[112:115], v202
    ds_read_b128 v[116:119], v203
    ds_read_b128 v[120:123], v204
    ds_read_b128 v[124:127], v205
    ds_read_b128 v[16:19], v1 offset:0
    ds_read_b128 v[20:23], v1 offset:1024
    ds_read_b128 v[24:27], v1 offset:2048
    ds_read_b128 v[28:31], v1 offset:3072
    ds_read_b128 v[32:35], v1 offset:4096
    ds_read_b128 v[36:39], v1 offset:5120
    ds_read_b128 v[40:43], v1 offset:6144
    ds_read_b128 v[44:47], v1 offset:7168
    ds_read_b128 v[48:51], v1 offset:8192
    ds_read_b128 v[52:55], v1 offset:9216
    ds_read_b128 v[56:59], v1 offset:10240
    ds_read_b128 v[60:63], v1 offset:11264
    ds_read_b128 v[64:67], v1 offset:12288
    ds_read_b128 v[68:71], v1 offset:13312
    ds_read_b128 v[72:75], v1 offset:14336
    ds_read_b128 v[76:79], v1 offset:15360
    ds_read_b128 v[80:83], v1 offset:16384
    ds_read_b128 v[84:87], v1 offset:17408
    s_waitcnt lgkmcnt(0)
    v_mfma_f32_32x32x16_bf16 v[136:151], v[112:115], v[236:239], 0
    v_mfma_f32_32x32x16_bf16 v[136:151], v[116:119], v[240:243], v[136:151]
    v_mfma_f32_32x32x16_bf16 v[136:151], v[120:123], v[244:247], v[136:151]
    v_mfma_f32_32x32x16_bf16 v[136:151], v[124:127], v[248:251], v[136:151]
    s_and_b32 s75, s30, 1
    s_lshl_b32 s75, s75, 5
    v_lshrrev_b32 v1, 5, v15
    v_lshl_add_u32 v1, v1, 2, s75
    v_mul_u32_u24 v1, 1408, v1
    s_bfe_u32 s76, s30, 0x10001
    s_cmp_ge_u32 s30, 4
    s_cbranch_scc1 K2_NG_U
    s_lshl_b32 s76, s76, 7
    v_add_u32 v1, v1, v8
    v_add_u32 v1, s76, v1
    s_mov_b32 s77, 0xbfb8aa3b
    s_nop 7
    v_mul_f32 v136, s77, v136
    v_cvt_pk_bf16_f32 v214, v136, v136
    v_lshlrev_b32 v214, 16, v214
    v_sub_f32 v215, v136, v214
    v_cvt_pk_bf16_f32 v136, v214, v215
    v_mul_f32 v137, s77, v137
    v_cvt_pk_bf16_f32 v214, v137, v137
    v_lshlrev_b32 v214, 16, v214
    v_sub_f32 v215, v137, v214
    v_cvt_pk_bf16_f32 v137, v214, v215
    v_mul_f32 v138, s77, v138
    v_cvt_pk_bf16_f32 v214, v138, v138
    v_lshlrev_b32 v214, 16, v214
    v_sub_f32 v215, v138, v214
    v_cvt_pk_bf16_f32 v138, v214, v215
    v_mul_f32 v139, s77, v139
    v_cvt_pk_bf16_f32 v214, v139, v139
    v_lshlrev_b32 v214, 16, v214
    v_sub_f32 v215, v139, v214
    v_cvt_pk_bf16_f32 v139, v214, v215
    v_mul_f32 v140, s77, v140
    v_cvt_pk_bf16_f32 v214, v140, v140
    v_lshlrev_b32 v214, 16, v214
    v_sub_f32 v215, v140, v214
    v_cvt_pk_bf16_f32 v140, v214, v215
    v_mul_f32 v141, s77, v141
    v_cvt_pk_bf16_f32 v214, v141, v141
    v_lshlrev_b32 v214, 16, v214
    v_sub_f32 v215, v141, v214
    v_cvt_pk_bf16_f32 v141, v214, v215
    v_mul_f32 v142, s77, v142
    v_cvt_pk_bf16_f32 v214, v142, v142
    v_lshlrev_b32 v214, 16, v214
    v_sub_f32 v215, v142, v214
    v_cvt_pk_bf16_f32 v142, v214, v215
    v_mul_f32 v143, s77, v143
    v_cvt_pk_bf16_f32 v214, v143, v143
    v_lshlrev_b32 v214, 16, v214
    v_sub_f32 v215, v143, v214
    v_cvt_pk_bf16_f32 v143, v214, v215
    v_mul_f32 v144, s77, v144
    v_cvt_pk_bf16_f32 v214, v144, v144
    v_lshlrev_b32 v214, 16, v214
    v_sub_f32 v215, v144, v214
    v_cvt_pk_bf16_f32 v144, v214, v215
    v_mul_f32 v145, s77, v145
    v_cvt_pk_bf16_f32 v214, v145, v145
    v_lshlrev_b32 v214, 16, v214
    v_sub_f32 v215, v145, v214
    v_cvt_pk_bf16_f32 v145, v214, v215
    v_mul_f32 v146, s77, v146
    v_cvt_pk_bf16_f32 v214, v146, v146
    v_lshlrev_b32 v214, 16, v214
    v_sub_f32 v215, v146, v214
    v_cvt_pk_bf16_f32 v146, v214, v215
    v_mul_f32 v147, s77, v147
    v_cvt_pk_bf16_f32 v214, v147, v147
    v_lshlrev_b32 v214, 16, v214
    v_sub_f32 v215, v147, v214
    v_cvt_pk_bf16_f32 v147, v214, v215
    v_mul_f32 v148, s77, v148
    v_cvt_pk_bf16_f32 v214, v148, v148
    v_lshlrev_b32 v214, 16, v214
    v_sub_f32 v215, v148, v214
    v_cvt_pk_bf16_f32 v148, v214, v215
    v_mul_f32 v149, s77, v149
    v_cvt_pk_bf16_f32 v214, v149, v149
    v_lshlrev_b32 v214, 16, v214
    v_sub_f32 v215, v149, v214
    v_cvt_pk_bf16_f32 v149, v214, v215
    v_mul_f32 v150, s77, v150
    v_cvt_pk_bf16_f32 v214, v150, v150
    v_lshlrev_b32 v214, 16, v214
    v_sub_f32 v215, v150, v214
    v_cvt_pk_bf16_f32 v150, v214, v215
    v_mul_f32 v151, s77, v151
    v_cvt_pk_bf16_f32 v214, v151, v151
    v_lshlrev_b32 v214, 16, v214
    v_sub_f32 v215, v151, v214
    v_cvt_pk_bf16_f32 v151, v214, v215
    ds_write_b32 v1, v136 offset:0
    ds_write_b32 v1, v137 offset:1408
    ds_write_b32 v1, v138 offset:2816
    ds_write_b32 v1, v139 offset:4224
    ds_write_b32 v1, v140 offset:11264
    ds_write_b32 v1, v141 offset:12672
    ds_write_b32 v1, v142 offset:14080
    ds_write_b32 v1, v143 offset:15488
    s_and_b32 s75, s30, 1
    s_cmp_eq_u32 s75, 0
    s_cbranch_scc0 K2_NG_A1
    ds_write_b32 v1, v144 offset:22528
    ds_write_b32 v1, v145 offset:23936
    ds_write_b32 v1, v146 offset:25344
    ds_write_b32 v1, v147 offset:26752
    ds_write_b32 v1, v148 offset:33792
    ds_write_b32 v1, v149 offset:35200
    ds_write_b32 v1, v150 offset:36608
    ds_write_b32 v1, v151 offset:38016
    s_branch K2_NG_BAR
K2_NG_A1:
    s_mov_b32 exec_lo, -1
    s_mov_b32 exec_hi, 0
    ds_write_b32 v1, v144 offset:22528
    ds_write_b32 v1, v145 offset:23936
    s_mov_b64 exec, -1
    s_branch K2_NG_BAR
K2_NG_U:
    s_lshl_b32 s76, s76, 6
    v_and_b32 v214, 31, v15
    v_lshl_add_u32 v1, v214, 1, v1
    v_add_u32 v1, s76, v1
    v_add_u32 v1, 66816, v1
    s_nop 7
    v_cvt_pk_bf16_f32 v136, v136, v136
    v_cvt_pk_bf16_f32 v137, v137, v137
    v_cvt_pk_bf16_f32 v138, v138, v138
    v_cvt_pk_bf16_f32 v139, v139, v139
    v_cvt_pk_bf16_f32 v140, v140, v140
    v_cvt_pk_bf16_f32 v141, v141, v141
    v_cvt_pk_bf16_f32 v142, v142, v142
    v_cvt_pk_bf16_f32 v143, v143, v143
    v_cvt_pk_bf16_f32 v144, v144, v144
    v_cvt_pk_bf16_f32 v145, v145, v145
    v_cvt_pk_bf16_f32 v146, v146, v146
    v_cvt_pk_bf16_f32 v147, v147, v147
    v_cvt_pk_bf16_f32 v148, v148, v148
    v_cvt_pk_bf16_f32 v149, v149, v149
    v_cvt_pk_bf16_f32 v150, v150, v150
    v_cvt_pk_bf16_f32 v151, v151, v151
    ds_write_b16 v1, v136 offset:0
    ds_write_b16 v1, v137 offset:1408
    ds_write_b16 v1, v138 offset:2816
    ds_write_b16 v1, v139 offset:4224
    ds_write_b16 v1, v140 offset:11264
    ds_write_b16 v1, v141 offset:12672
    ds_write_b16 v1, v142 offset:14080
    ds_write_b16 v1, v143 offset:15488
    s_and_b32 s75, s30, 1
    s_cmp_eq_u32 s75, 0
    s_cbranch_scc0 K2_NG_U1
    ds_write_b16 v1, v144 offset:22528
    ds_write_b16 v1, v145 offset:23936
    ds_write_b16 v1, v146 offset:25344
    ds_write_b16 v1, v147 offset:26752
    ds_write_b16 v1, v148 offset:33792
    ds_write_b16 v1, v149 offset:35200
    ds_write_b16 v1, v150 offset:36608
    ds_write_b16 v1, v151 offset:38016
    s_branch K2_NG_BAR
K2_NG_U1:
    s_mov_b32 exec_lo, -1
    s_mov_b32 exec_hi, 0
    ds_write_b16 v1, v144 offset:22528
    ds_write_b16 v1, v145 offset:23936
    s_mov_b64 exec, -1
K2_NG_BAR:
    s_waitcnt lgkmcnt(0)
    s_barrier
K2_NG_DONE:
    s_mov_b32 s37, 0
    s_cmp_lt_u32 s32, s31
    s_cbranch_scc0 K2_LOOP_END
    ds_read2_b32 v[200:201], v4 offset0:128 offset1:132
    ds_read_b32 v206, v5 offset:1024
    v_mad_u32_u16 v210, v208, 64, v8 op_sel:[0,0,0,0]
    v_mad_u32_u16 v211, v208, 64, v8 op_sel:[1,0,0,0]
    v_mad_u32_u16 v213, v208, 64, v9 op_sel:[1,0,0,0]
    ds_read2_b32 v[88:89], v210 offset0:0 offset1:32
    ds_read2_b32 v[90:91], v211 offset0:0 offset1:32
    v_mov_b32 v160, 0
    v_mov_b32 v192, 0
    v_mov_b32 v161, 0
    v_mov_b32 v193, 0
    v_mov_b32 v162, 0
    v_mov_b32 v194, 0
    v_mov_b32 v163, 0
    v_mov_b32 v195, 0
    v_mov_b32 v164, 0
    v_mov_b32 v196, 0
    v_mov_b32 v165, 0
    v_mov_b32 v197, 0
    v_mov_b32 v166, 0
    v_mov_b32 v198, 0
    v_mov_b32 v167, 0
    v_mov_b32 v199, 0
    s_waitcnt lgkmcnt(2)
    s_mov_b32 m0, s34
    v_mad_u32_u16 v202, v200, s83, v252 op_sel:[0,0,0,0]
    buffer_load_dwordx4 v202, s[64:67], 0 offen offset:0 lds
    v_mad_u32_u16 v203, v200, s83, v253 op_sel:[1,0,0,0]
    buffer_load_dwordx4 v203, s[64:67], 0 offen offset:1024 lds
    v_mad_u32_u16 v204, v201, s83, v254 op_sel:[0,0,0,0]
    buffer_load_dwordx4 v204, s[64:67], 0 offen offset:2048 lds
    v_mad_u32_u16 v205, v201, s83, v255 op_sel:[1,0,0,0]
    buffer_load_dwordx4 v205, s[64:67], 0 offen offset:3072 lds
    v_mad_u32_u24 v207, v206, 32, v6
    buffer_load_dwordx4 v[132:135], v207, s[8:11], 0 offen nt
    v_and_b32 v108, 0xff000000, v206
    v_add_u32 v4, 1024, v4
    ds_read2_b32 v[200:201], v4 offset0:0 offset1:4
    s_waitcnt vmcnt(5)
    ds_read_b128 v[112:115], v10
    ds_read_b128 v[116:119], v11
    ds_read_b128 v[120:123], v12
    ds_read_b128 v[124:127], v13
    v_add_u32 v4, 512, v4
    v_add_u32 v5, 2048, v5
    v_add_u32 v7, 64, v7
    s_waitcnt lgkmcnt(0)
    v_mfma_f32_32x32x16_bf16 v[136:151], v[112:115], v[16:19], 0
    v_mfma_f32_32x32x16_bf16 v[136:151], v[116:119], v[20:23], v[136:151]
    v_mfma_f32_32x32x16_bf16 v[136:151], v[120:123], v[24:27], v[136:151]
    v_mfma_f32_32x32x16_bf16 v[136:151], v[124:127], v[28:31], v[136:151]
    v_mfma_f32_32x32x16_bf16 v[136:151], v[128:131], v[80:83], v[136:151]
    v_mfma_f32_32x32x16_bf16 v[136:151], v[92:95], v[88:91], v[136:151]
    s_nop 7
    s_nop 2
K2_LOOP:
    v_mfma_f32_32x32x16_bf16 v[168:183], v[112:115], v[48:51], 0
    s_mov_b32 m0, s33
    v_mad_u32_u16 v202, v200, s83, v252 op_sel:[0,0,0,0]
    buffer_load_dwordx4 v202, s[64:67], 0 offen offset:0 lds
    v_exp_f32 v136, v136
    v_exp_f32 v137, v137
    v_exp_f32 v138, v138
    v_exp_f32 v139, v139
    v_mfma_f32_32x32x16_bf16 v[168:183], v[116:119], v[52:55], v[168:183]
    v_mad_u32_u16 v203, v200, s83, v253 op_sel:[1,0,0,0]
    buffer_load_dwordx4 v203, s[64:67], 0 offen offset:1024 lds
    v_exp_f32 v140, v140
    v_exp_f32 v141, v141
    v_exp_f32 v142, v142
    v_exp_f32 v143, v143
    v_mfma_f32_32x32x16_bf16 v[168:183], v[120:123], v[56:59], v[168:183]
    v_mad_u32_u16 v204, v201, s83, v254 op_sel:[0,0,0,0]
    buffer_load_dwordx4 v204, s[64:67], 0 offen offset:2048 lds
    v_exp_f32 v144, v144
    v_exp_f32 v145, v145
    v_exp_f32 v146, v146
    v_exp_f32 v147, v147
    v_mfma_f32_32x32x16_bf16 v[168:183], v[124:127], v[60:63], v[168:183]
    v_mad_u32_u16 v205, v201, s83, v255 op_sel:[1,0,0,0]
    buffer_load_dwordx4 v205, s[64:67], 0 offen offset:3072 lds
    v_exp_f32 v148, v148
    v_exp_f32 v149, v149
    v_exp_f32 v150, v150
    v_exp_f32 v151, v151
    v_mul_f32 v215, v160, v192
    v_add_f32 v214, v160, v161
    v_mfma_f32_32x32x16_bf16 v[136:151], v[104:107], v[100:103], v[136:151]
    v_fmac_f32 v215, v161, v193
    v_fmac_f32 v215, v162, v194
    v_add_f32 v214, v214, v162
    v_fmac_f32 v215, v163, v195
    v_add_f32 v214, v214, v163
    v_fmac_f32 v215, v164, v196
    v_add_f32 v214, v214, v164
    v_fmac_f32 v215, v165, v197
    v_add_f32 v214, v214, v165
    v_fmac_f32 v215, v166, v198
    v_add_f32 v214, v214, v166
    v_fmac_f32 v215, v167, v199
    v_add_f32 v214, v214, v167
    v_cvt_f64_f32 v[216:217], v214
    v_cvt_f64_f32 v[218:219], v215
    ds_add_f64 v213, v[216:217] offset:256
    ds_add_f64 v213, v[218:219] offset:768
    v_mad_u32_u16 v212, v208, 64, v9 op_sel:[0,0,0,0]
    v_mad_u32_u16 v213, v208, 64, v9 op_sel:[1,0,0,0]
    v_mfma_f32_32x32x16_bf16 v[152:167], v[112:115], v[32:35], 0
    v_rcp_f32 v136, v136
    v_rcp_f32 v137, v137
    v_rcp_f32 v138, v138
    v_mfma_f32_32x32x16_bf16 v[152:167], v[116:119], v[36:39], v[152:167]
    v_rcp_f32 v139, v139
    v_rcp_f32 v140, v140
    v_rcp_f32 v141, v141
    v_mfma_f32_32x32x16_bf16 v[152:167], v[120:123], v[40:43], v[152:167]
    v_rcp_f32 v142, v142
    v_rcp_f32 v143, v143
    v_rcp_f32 v144, v144
    v_mfma_f32_32x32x16_bf16 v[152:167], v[124:127], v[44:47], v[152:167]
    v_rcp_f32 v145, v145
    v_rcp_f32 v146, v146
    v_rcp_f32 v147, v147
    v_mfma_f32_32x32x16_bf16 v[152:167], v[128:131], v[84:87], v[152:167]
    v_rcp_f32 v148, v148
    v_rcp_f32 v149, v149
    v_rcp_f32 v150, v150
    v_mfma_f32_32x32x16_bf16 v[152:167], v[96:99], v[88:91], v[152:167]
    v_rcp_f32 v151, v151
    v_mul_f32 v215, v136, v168
    v_add_f32 v214, v136, v137
    v_fmac_f32 v215, v137, v169
    v_fmac_f32 v215, v138, v170
    v_add_f32 v214, v214, v138
    v_fmac_f32 v215, v139, v171
    v_add_f32 v214, v214, v139
    v_fmac_f32 v215, v140, v172
    v_add_f32 v214, v214, v140
    v_fmac_f32 v215, v141, v173
    v_add_f32 v214, v214, v141
    v_fmac_f32 v215, v142, v174
    v_add_f32 v214, v214, v142
    v_fmac_f32 v215, v143, v175
    v_add_f32 v214, v214, v143
    v_cvt_f64_f32 v[216:217], v214
    v_cvt_f64_f32 v[218:219], v215
    ds_add_f64 v212, v[216:217] offset:0
    ds_add_f64 v212, v[218:219] offset:512
    s_waitcnt vmcnt(5)
    ds_read2_b32 v[200:201], v4 offset0:0 offset1:4
    ds_read_b32 v206, v5 offset:0
    ds_read_b32 v209, v7 offset:0
    v_mfma_f32_32x32x16_bf16 v[184:199], v[112:115], v[64:67], 0
    ds_read_b128 v[112:115], v10 offset:32768
    v_exp_f32 v152, v152
    v_exp_f32 v153, v153
    v_exp_f32 v154, v154
    v_exp_f32 v155, v155
    v_mfma_f32_32x32x16_bf16 v[184:199], v[116:119], v[68:71], v[184:199]
    ds_read_b128 v[116:119], v11 offset:32768
    v_exp_f32 v156, v156
    v_exp_f32 v157, v157
    v_exp_f32 v158, v158
    v_exp_f32 v159, v159
    v_mfma_f32_32x32x16_bf16 v[184:199], v[120:123], v[72:75], v[184:199]
    ds_read_b128 v[120:123], v12 offset:32768
    v_exp_f32 v160, v160
    v_exp_f32 v161, v161
    v_exp_f32 v162, v162
    v_exp_f32 v163, v163
    v_mfma_f32_32x32x16_bf16 v[184:199], v[124:127], v[76:79], v[184:199]
    ds_read_b128 v[124:127], v13 offset:32768
    v_exp_f32 v164, v164
    v_exp_f32 v165, v165
    v_exp_f32 v166, v166
    v_exp_f32 v167, v167
    v_mul_f32 v215, v144, v176
    v_add_f32 v214, v144, v145
    v_mfma_f32_32x32x16_bf16 v[152:167], v[104:107], v[100:103], v[152:167]
    s_waitcnt lgkmcnt(4)
    v_mad_u32_u16 v210, v209, 64, v8 op_sel:[0,0,0,0]
    v_mad_u32_u16 v211, v209, 64, v8 op_sel:[1,0,0,0]
    v_mad_u32_u24 v207, v206, 32, v6
    buffer_load_dwordx4 v[128:131], v207, s[8:11], 0 offen nt
    ds_read2_b32 v[88:89], v210 offset0:0 offset1:32
    ds_read2_b32 v[90:91], v211 offset0:0 offset1:32
    v_and_b32 v104, 0xff000000, v206
    v_fmac_f32 v215, v145, v177
    v_fmac_f32 v215, v146, v178
    v_add_f32 v214, v214, v146
    v_fmac_f32 v215, v147, v179
    v_add_f32 v214, v214, v147
    v_fmac_f32 v215, v148, v180
    v_add_f32 v214, v214, v148
    v_fmac_f32 v215, v149, v181
    v_add_f32 v214, v214, v149
    v_fmac_f32 v215, v150, v182
    v_add_f32 v214, v214, v150
    v_fmac_f32 v215, v151, v183
    v_add_f32 v214, v214, v151
    v_cvt_f64_f32 v[216:217], v214
    v_cvt_f64_f32 v[218:219], v215
    ds_add_f64 v213, v[216:217] offset:0
    ds_add_f64 v213, v[218:219] offset:512
    s_waitcnt vmcnt(5) lgkmcnt(4)
    v_mfma_f32_32x32x16_bf16 v[136:151], v[112:115], v[16:19], 0
    v_rcp_f32 v152, v152
    v_rcp_f32 v153, v153
    v_rcp_f32 v154, v154
    v_mfma_f32_32x32x16_bf16 v[136:151], v[116:119], v[20:23], v[136:151]
    v_rcp_f32 v155, v155
    v_rcp_f32 v156, v156
    v_rcp_f32 v157, v157
    v_mfma_f32_32x32x16_bf16 v[136:151], v[120:123], v[24:27], v[136:151]
    v_rcp_f32 v158, v158
    v_rcp_f32 v159, v159
    v_rcp_f32 v160, v160
    v_mfma_f32_32x32x16_bf16 v[136:151], v[124:127], v[28:31], v[136:151]
    v_rcp_f32 v161, v161
    v_rcp_f32 v162, v162
    v_rcp_f32 v163, v163
    v_mfma_f32_32x32x16_bf16 v[136:151], v[132:135], v[80:83], v[136:151]
    v_rcp_f32 v164, v164
    v_rcp_f32 v165, v165
    v_rcp_f32 v166, v166
    s_waitcnt lgkmcnt(2)
    v_mfma_f32_32x32x16_bf16 v[136:151], v[92:95], v[88:91], v[136:151]
    v_rcp_f32 v167, v167
    v_mul_f32 v215, v152, v184
    v_add_f32 v214, v152, v153
    v_fmac_f32 v215, v153, v185
    v_fmac_f32 v215, v154, v186
    v_add_f32 v214, v214, v154
    v_fmac_f32 v215, v155, v187
    v_add_f32 v214, v214, v155
    v_fmac_f32 v215, v156, v188
    v_add_f32 v214, v214, v156
    v_fmac_f32 v215, v157, v189
    v_add_f32 v214, v214, v157
    v_fmac_f32 v215, v158, v190
    v_add_f32 v214, v214, v158
    v_fmac_f32 v215, v159, v191
    v_add_f32 v214, v214, v159
    v_cvt_f64_f32 v[216:217], v214
    v_cvt_f64_f32 v[218:219], v215
    ds_add_f64 v212, v[216:217] offset:256
    ds_add_f64 v212, v[218:219] offset:768
    s_add_u32 s32, s32, 8
    s_cmp_lt_u32 s32, s31
    s_cbranch_scc0 K2_TAIL
    v_mfma_f32_32x32x16_bf16 v[168:183], v[112:115], v[48:51], 0
    s_mov_b32 m0, s34
    v_mad_u32_u16 v202, v200, s83, v252 op_sel:[0,0,0,0]
    buffer_load_dwordx4 v202, s[64:67], 0 offen offset:0 lds
    v_exp_f32 v136, v136
    v_exp_f32 v137, v137
    v_exp_f32 v138, v138
    v_exp_f32 v139, v139
    v_mfma_f32_32x32x16_bf16 v[168:183], v[116:119], v[52:55], v[168:183]
    v_mad_u32_u16 v203, v200, s83, v253 op_sel:[1,0,0,0]
    buffer_load_dwordx4 v203, s[64:67], 0 offen offset:1024 lds
    v_exp_f32 v140, v140
    v_exp_f32 v141, v141
    v_exp_f32 v142, v142
    v_exp_f32 v143, v143
    v_mfma_f32_32x32x16_bf16 v[168:183], v[120:123], v[56:59], v[168:183]
    v_mad_u32_u16 v204, v201, s83, v254 op_sel:[0,0,0,0]
    buffer_load_dwordx4 v204, s[64:67], 0 offen offset:2048 lds
    v_exp_f32 v144, v144
    v_exp_f32 v145, v145
    v_exp_f32 v146, v146
    v_exp_f32 v147, v147
    v_mfma_f32_32x32x16_bf16 v[168:183], v[124:127], v[60:63], v[168:183]
    v_mad_u32_u16 v205, v201, s83, v255 op_sel:[1,0,0,0]
    buffer_load_dwordx4 v205, s[64:67], 0 offen offset:3072 lds
    v_exp_f32 v148, v148
    v_exp_f32 v149, v149
    v_exp_f32 v150, v150
    v_exp_f32 v151, v151
    v_mul_f32 v215, v160, v192
    v_add_f32 v214, v160, v161
    v_mfma_f32_32x32x16_bf16 v[136:151], v[108:111], v[100:103], v[136:151]
    v_fmac_f32 v215, v161, v193
    v_fmac_f32 v215, v162, v194
    v_add_f32 v214, v214, v162
    v_fmac_f32 v215, v163, v195
    v_add_f32 v214, v214, v163
    v_fmac_f32 v215, v164, v196
    v_add_f32 v214, v214, v164
    v_fmac_f32 v215, v165, v197
    v_add_f32 v214, v214, v165
    v_fmac_f32 v215, v166, v198
    v_add_f32 v214, v214, v166
    v_fmac_f32 v215, v167, v199
    v_add_f32 v214, v214, v167
    v_cvt_f64_f32 v[216:217], v214
    v_cvt_f64_f32 v[218:219], v215
    ds_add_f64 v213, v[216:217] offset:256
    ds_add_f64 v213, v[218:219] offset:768
    v_mad_u32_u16 v212, v209, 64, v9 op_sel:[0,0,0,0]
    v_mad_u32_u16 v213, v209, 64, v9 op_sel:[1,0,0,0]
    v_mfma_f32_32x32x16_bf16 v[152:167], v[112:115], v[32:35], 0
    v_rcp_f32 v136, v136
    v_rcp_f32 v137, v137
    v_rcp_f32 v138, v138
    v_mfma_f32_32x32x16_bf16 v[152:167], v[116:119], v[36:39], v[152:167]
    v_rcp_f32 v139, v139
    v_rcp_f32 v140, v140
    v_rcp_f32 v141, v141
    v_mfma_f32_32x32x16_bf16 v[152:167], v[120:123], v[40:43], v[152:167]
    v_rcp_f32 v142, v142
    v_rcp_f32 v143, v143
    v_rcp_f32 v144, v144
    v_mfma_f32_32x32x16_bf16 v[152:167], v[124:127], v[44:47], v[152:167]
    v_rcp_f32 v145, v145
    v_rcp_f32 v146, v146
    v_rcp_f32 v147, v147
    v_mfma_f32_32x32x16_bf16 v[152:167], v[132:135], v[84:87], v[152:167]
    v_rcp_f32 v148, v148
    v_rcp_f32 v149, v149
    v_rcp_f32 v150, v150
    v_mfma_f32_32x32x16_bf16 v[152:167], v[96:99], v[88:91], v[152:167]
    v_rcp_f32 v151, v151
    v_mul_f32 v215, v136, v168
    v_add_f32 v214, v136, v137
    v_fmac_f32 v215, v137, v169
    v_fmac_f32 v215, v138, v170
    v_add_f32 v214, v214, v138
    v_fmac_f32 v215, v139, v171
    v_add_f32 v214, v214, v139
    v_fmac_f32 v215, v140, v172
    v_add_f32 v214, v214, v140
    v_fmac_f32 v215, v141, v173
    v_add_f32 v214, v214, v141
    v_fmac_f32 v215, v142, v174
    v_add_f32 v214, v214, v142
    v_fmac_f32 v215, v143, v175
    v_add_f32 v214, v214, v143
    v_cvt_f64_f32 v[216:217], v214
    v_cvt_f64_f32 v[218:219], v215
    ds_add_f64 v212, v[216:217] offset:0
    ds_add_f64 v212, v[218:219] offset:512
    s_waitcnt vmcnt(5)
    ds_read2_b32 v[200:201], v4 offset0:128 offset1:132
    ds_read_b32 v206, v5 offset:1024
    ds_read_b32 v208, v7 offset:64
    v_mfma_f32_32x32x16_bf16 v[184:199], v[112:115], v[64:67], 0
    ds_read_b128 v[112:115], v10 offset:0
    v_exp_f32 v152, v152
    v_exp_f32 v153, v153
    v_exp_f32 v154, v154
    v_exp_f32 v155, v155
    v_mfma_f32_32x32x16_bf16 v[184:199], v[116:119], v[68:71], v[184:199]
    ds_read_b128 v[116:119], v11 offset:0
    v_exp_f32 v156, v156
    v_exp_f32 v157, v157
    v_exp_f32 v158, v158
    v_exp_f32 v159, v159
    v_mfma_f32_32x32x16_bf16 v[184:199], v[120:123], v[72:75], v[184:199]
    ds_read_b128 v[120:123], v12 offset:0
    v_exp_f32 v160, v160
    v_exp_f32 v161, v161
    v_exp_f32 v162, v162
    v_exp_f32 v163, v163
    v_mfma_f32_32x32x16_bf16 v[184:199], v[124:127], v[76:79], v[184:199]
    ds_read_b128 v[124:127], v13 offset:0
    v_exp_f32 v164, v164
    v_exp_f32 v165, v165
    v_exp_f32 v166, v166
    v_exp_f32 v167, v167
    v_mul_f32 v215, v144, v176
    v_add_f32 v214, v144, v145
    v_mfma_f32_32x32x16_bf16 v[152:167], v[108:111], v[100:103], v[152:167]
    s_waitcnt lgkmcnt(4)
    v_mad_u32_u16 v210, v208, 64, v8 op_sel:[0,0,0,0]
    v_mad_u32_u16 v211, v208, 64, v8 op_sel:[1,0,0,0]
    v_mad_u32_u24 v207, v206, 32, v6
    buffer_load_dwordx4 v[132:135], v207, s[8:11], 0 offen nt
    ds_read2_b32 v[88:89], v210 offset0:0 offset1:32
    ds_read2_b32 v[90:91], v211 offset0:0 offset1:32
    v_and_b32 v108, 0xff000000, v206
    v_fmac_f32 v215, v145, v177
    v_fmac_f32 v215, v146, v178
    v_add_f32 v214, v214, v146
    v_fmac_f32 v215, v147, v179
    v_add_f32 v214, v214, v147
    v_fmac_f32 v215, v148, v180
    v_add_f32 v214, v214, v148
    v_fmac_f32 v215, v149, v181
    v_add_f32 v214, v214, v149
    v_fmac_f32 v215, v150, v182
    v_add_f32 v214, v214, v150
    v_fmac_f32 v215, v151, v183
    v_add_f32 v214, v214, v151
    v_cvt_f64_f32 v[216:217], v214
    v_cvt_f64_f32 v[218:219], v215
    ds_add_f64 v213, v[216:217] offset:0
    ds_add_f64 v213, v[218:219] offset:512
    s_waitcnt vmcnt(5) lgkmcnt(4)
    v_mfma_f32_32x32x16_bf16 v[136:151], v[112:115], v[16:19], 0
    v_rcp_f32 v152, v152
    v_rcp_f32 v153, v153
    v_rcp_f32 v154, v154
    v_mfma_f32_32x32x16_bf16 v[136:151], v[116:119], v[20:23], v[136:151]
    v_rcp_f32 v155, v155
    v_rcp_f32 v156, v156
    v_rcp_f32 v157, v157
    v_mfma_f32_32x32x16_bf16 v[136:151], v[120:123], v[24:27], v[136:151]
    v_rcp_f32 v158, v158
    v_rcp_f32 v159, v159
    v_rcp_f32 v160, v160
    v_mfma_f32_32x32x16_bf16 v[136:151], v[124:127], v[28:31], v[136:151]
    v_rcp_f32 v161, v161
    v_rcp_f32 v162, v162
    v_rcp_f32 v163, v163
    v_mfma_f32_32x32x16_bf16 v[136:151], v[128:131], v[80:83], v[136:151]
    v_rcp_f32 v164, v164
    v_rcp_f32 v165, v165
    v_rcp_f32 v166, v166
    s_waitcnt lgkmcnt(2)
    v_mfma_f32_32x32x16_bf16 v[136:151], v[92:95], v[88:91], v[136:151]
    v_rcp_f32 v167, v167
    v_mul_f32 v215, v152, v184
    v_add_f32 v214, v152, v153
    v_fmac_f32 v215, v153, v185
    v_fmac_f32 v215, v154, v186
    v_add_f32 v214, v214, v154
    v_fmac_f32 v215, v155, v187
    v_add_f32 v214, v214, v155
    v_fmac_f32 v215, v156, v188
    v_add_f32 v214, v214, v156
    v_fmac_f32 v215, v157, v189
    v_add_f32 v214, v214, v157
    v_fmac_f32 v215, v158, v190
    v_add_f32 v214, v214, v158
    v_fmac_f32 v215, v159, v191
    v_add_f32 v214, v214, v159
    v_cvt_f64_f32 v[216:217], v214
    v_cvt_f64_f32 v[218:219], v215
    ds_add_f64 v212, v[216:217] offset:256
    ds_add_f64 v212, v[218:219] offset:768
    v_add_u32 v4, 1024, v4
    v_add_u32 v5, 2048, v5
    v_add_u32 v7, 128, v7
    s_add_u32 s32, s32, 8
    s_cmp_lt_u32 s32, s31
    s_cbranch_scc1 K2_LOOP
K2_TAIL:
    v_mul_f32 v215, v160, v192
    v_add_f32 v214, v160, v161
    v_fmac_f32 v215, v161, v193
    v_fmac_f32 v215, v162, v194
    v_add_f32 v214, v214, v162
    v_fmac_f32 v215, v163, v195
    v_add_f32 v214, v214, v163
    v_fmac_f32 v215, v164, v196
    v_add_f32 v214, v214, v164
    v_fmac_f32 v215, v165, v197
    v_add_f32 v214, v214, v165
    v_fmac_f32 v215, v166, v198
    v_add_f32 v214, v214, v166
    v_fmac_f32 v215, v167, v199
    v_add_f32 v214, v214, v167
    v_cvt_f64_f32 v[216:217], v214
    v_cvt_f64_f32 v[218:219], v215
    ds_add_f64 v213, v[216:217] offset:256
    ds_add_f64 v213, v[218:219] offset:768
K2_LOOP_END:
    s_waitcnt vmcnt(0)
    v_lshrrev_b32 v1, 3, v0
    v_and_b32 v2, 7, v0
    v_lshlrev_b32 v3, 8, v1
    v_add_u32 v3, s3, v3
    v_lshlrev_b32 v3, 7, v3
    v_lshl_add_u32 v3, v2, 4, v3
    buffer_load_dwordx4 v[236:239], v3, s[4:7], 0 offen
    v_mul_u32_u24 v14, 1408, v1
    v_add_u32 v14, 65536, v14
    v_lshl_add_u32 v240, v2, 6, v14
    v_lshl_add_u32 v241, v2, 4, v14
    s_waitcnt lgkmcnt(0)
    s_barrier
    s_cmp_eq_u32 s36, 1
    s_cbranch_scc1 K2_NEXT_SPLIT
    s_cmp_eq_u32 s36, 2
    s_cbranch_scc1 K2_NEXT_OVF
K2_CHECK_OVF:
    s_cmp_eq_u32 s38, 0
    s_cbranch_scc1 K2_EPI
    s_mov_b32 s36, 2
    s_mov_b32 s94, 0
    s_mov_b32 s79, 0
    s_branch K2_OVF_FIND
K2_SPLIT:
    s_mov_b32 s36, 1
    s_mov_b32 s39, 0
    s_waitcnt lgkmcnt(0)
    s_barrier
    s_branch K2_LOADQ
K2_NEXT_SPLIT:
    s_add_u32 s39, s39, 1
    s_cmp_ge_u32 s39, 4
    s_cbranch_scc1 K2_CHECK_OVF
K2_LOADQ:
    s_and_b32 s75, s39, 1
    s_lshl_b32 s75, s75, 7
    v_lshrrev_b32 v4, 2, v0
    v_add_u32 v4, s75, v4
    v_and_b32 v5, 3, v0
    v_add_u32 v198, s82, v4
    v_and_b32 v198, 255, v198
    v_lshlrev_b32 v198, 7, v198
    v_lshl_add_u32 v198, v5, 4, v198
    v_add_u32 v198, s35, v198
    v_cmp_gt_u32 vcc, 250, v4
    v_mov_b32 v14, 0x7fffffff
    s_nop 0
    v_cndmask_b32 v198, v14, v198, vcc
    s_waitcnt vmcnt(0)
    buffer_load_dwordx4 v[136:139], v198, s[12:15], 0 offen
    v_mov_b32 v140, 0
    v_mov_b32 v141, 0
    v_mov_b32 v142, 0
    v_mov_b32 v143, 0
    v_mov_b32 v144, 0
    v_mov_b32 v145, 0
    v_mov_b32 v146, 0
    v_mov_b32 v147, 0
    v_mov_b32 v148, 0
    v_mov_b32 v149, 0
    v_mov_b32 v150, 0
    v_mov_b32 v151, 0
    s_cmp_ge_u32 s39, 2
    s_cbranch_scc0 K2_LOADQ_A
    s_waitcnt vmcnt(0)
    v_mov_b32_dpp v14, v139 quad_perm:[3,3,3,3] row_mask:0xf bank_mask:0xf
    s_nop 0
    v_cmp_ne_u32 vcc, 0, v14
    v_mov_b32 v136, 0
    v_mov_b32 v137, 0
    v_mov_b32 v138, 0
    v_mov_b32 v139, 0
    s_mov_b64 exec, vcc
    s_cbranch_execz K2_LOADQ_B
    buffer_load_dwordx4 v[136:139], v198, s[12:15], s81 offen
K2_LOADQ_B:
    s_mov_b64 exec, -1
K2_LOADQ_A:
    v_mul_u32_u24 v4, 3200, v4
    v_add_u32 v168, 0x3fffffff, v4
    s_branch K2_ROUND
K2_NEXT_OVF:
    s_add_u32 s79, s79, 2048
K2_OVF_FIND:
    s_cmp_ge_u32 s94, s38
    s_cbranch_scc1 K2_EPI
    s_lshl_b32 s75, s94, 1
    s_add_u32 s75, s75, 162052
    v_mov_b32 v14, s75
    ds_read_u16 v14, v14
    s_waitcnt lgkmcnt(0)
    v_readfirstlane_b32 s78, v14
    s_nop 3
    s_lshl_b32 s75, s78, 2
    s_add_u32 s75, s75, 8388608
    s_load_dword s80, s[28:29], s75
    s_waitcnt lgkmcnt(0)
    s_cmp_gt_u32 s80, s79
    s_cbranch_scc1 K2_OVF_LOAD
    s_add_u32 s94, s94, 1
    s_mov_b32 s79, 0
    s_branch K2_OVF_FIND
K2_OVF_LOAD:
    s_mul_i32 s75, s78, 25600
    s_add_u32 s75, s75, 8454144
    s_add_u32 s24, s28, s75
    s_addc_u32 s25, s29, 0
    s_lshl_b32 s26, s80, 3
    s_mov_b32 s27, 0x20000
    v_add_u32 v1, s79, v0
    v_lshlrev_b32 v1, 3, v1
    buffer_load_dwordx2 v[112:113], v1, s[24:27], 0 offen
    s_mov_b32 s75, 4096
    buffer_load_dwordx2 v[114:115], v1, s[24:27], s75 offen
    s_mov_b32 s75, 8192
    buffer_load_dwordx2 v[116:117], v1, s[24:27], s75 offen
    s_mov_b32 s75, 12288
    buffer_load_dwordx2 v[118:119], v1, s[24:27], s75 offen
    s_waitcnt vmcnt(0)
    v_cmp_eq_u32 vcc, s3, v113
    s_nop 1
    v_cndmask_b32 v136, 0, v112, vcc
    v_cmp_eq_u32 vcc, s3, v115
    s_nop 1
    v_cndmask_b32 v137, 0, v114, vcc
    v_cmp_eq_u32 vcc, s3, v117
    s_nop 1
    v_cndmask_b32 v138, 0, v116, vcc
    v_cmp_eq_u32 vcc, s3, v119
    s_nop 1
    v_cndmask_b32 v139, 0, v118, vcc
    v_mov_b32 v140, 0
    v_mov_b32 v141, 0
    v_mov_b32 v142, 0
    v_mov_b32 v143, 0
    v_mov_b32 v144, 0
    v_mov_b32 v145, 0
    v_mov_b32 v146, 0
    v_mov_b32 v147, 0
    v_mov_b32 v148, 0
    v_mov_b32 v149, 0
    v_mov_b32 v150, 0
    v_mov_b32 v151, 0
    s_mul_i32 s75, s78, 3200
    s_add_u32 s75, s75, 0x3fffffff
    v_mov_b32 v168, s75
    s_branch K2_ROUND
K2_EPI:
    ds_read_b128 v[48:51], v240 offset:256
    ds_read_b128 v[52:55], v240 offset:272
    ds_read_b128 v[56:59], v240 offset:288
    ds_read_b128 v[60:63], v240 offset:304
    ds_read_b128 v[36:39], v241 offset:1280
    ds_read_b128 v[64:67], v240 offset:768
    ds_read_b128 v[68:71], v240 offset:784
    ds_read_b128 v[72:75], v240 offset:800
    ds_read_b128 v[76:79], v240 offset:816
    s_mov_b32 s40, 0x358637bd
    s_waitcnt lgkmcnt(5)
    v_cvt_f32_f64 v20, v[48:49]
    v_cvt_f32_f64 v21, v[50:51]
    v_cvt_f32_f64 v22, v[52:53]
    v_cvt_f32_f64 v23, v[54:55]
    v_cvt_f32_f64 v24, v[56:57]
    v_cvt_f32_f64 v25, v[58:59]
    v_cvt_f32_f64 v26, v[60:61]
    v_cvt_f32_f64 v27, v[62:63]
    v_add_f32 v20, s40, v20
    v_add_f32 v21, s40, v21
    v_add_f32 v22, s40, v22
    v_add_f32 v23, s40, v23
    v_add_f32 v24, s40, v24
    v_add_f32 v25, s40, v25
    v_add_f32 v26, s40, v26
    v_add_f32 v27, s40, v27
    v_rcp_f32 v20, v20
    v_rcp_f32 v21, v21
    v_rcp_f32 v22, v22
    v_rcp_f32 v23, v23
    v_rcp_f32 v24, v24
    v_rcp_f32 v25, v25
    v_rcp_f32 v26, v26
    v_rcp_f32 v27, v27
    s_waitcnt lgkmcnt(4)
    v_lshlrev_b32 v40, 16, v36
    v_and_b32 v41, 0xffff0000, v36
    v_lshlrev_b32 v42, 16, v37
    v_and_b32 v43, 0xffff0000, v37
    v_lshlrev_b32 v44, 16, v38
    v_and_b32 v45, 0xffff0000, v38
    v_lshlrev_b32 v46, 16, v39
    v_and_b32 v47, 0xffff0000, v39
    s_waitcnt lgkmcnt(0)
    v_cvt_f32_f64 v28, v[64:65]
    v_cvt_f32_f64 v29, v[66:67]
    v_cvt_f32_f64 v30, v[68:69]
    v_cvt_f32_f64 v31, v[70:71]
    v_cvt_f32_f64 v32, v[72:73]
    v_cvt_f32_f64 v33, v[74:75]
    v_cvt_f32_f64 v34, v[76:77]
    v_cvt_f32_f64 v35, v[78:79]
    v_fmac_f32 v40, v28, v20
    v_fmac_f32 v41, v29, v21
    v_fmac_f32 v42, v30, v22
    v_fmac_f32 v43, v31, v23
    v_fmac_f32 v44, v32, v24
    v_fmac_f32 v45, v33, v25
    v_fmac_f32 v46, v34, v26
    v_fmac_f32 v47, v35, v27
    v_cmp_lt_f32 s[42:43], 0, v40
    v_cmp_lt_f32 s[44:45], 0, v41
    v_cmp_lt_f32 s[46:47], 0, v42
    v_cmp_lt_f32 s[48:49], 0, v43
    v_cmp_lt_f32 s[50:51], 0, v44
    v_cmp_lt_f32 s[52:53], 0, v45
    v_cmp_lt_f32 s[54:55], 0, v46
    v_cmp_lt_f32 s[56:57], 0, v47
    v_mul_f32 v28, 0, v40
    v_mul_f32 v29, 0, v41
    v_mul_f32 v30, 0, v42
    v_mul_f32 v31, 0, v43
    v_mul_f32 v32, 0, v44
    v_mul_f32 v33, 0, v45
    v_mul_f32 v34, 0, v46
    v_mul_f32 v35, 0, v47
    v_cndmask_b32 v28, v28, v40, s[42:43]
    v_cndmask_b32 v29, v29, v41, s[44:45]
    v_cndmask_b32 v30, v30, v42, s[46:47]
    v_cndmask_b32 v31, v31, v43, s[48:49]
    v_cndmask_b32 v32, v32, v44, s[50:51]
    v_cndmask_b32 v33, v33, v45, s[52:53]
    v_cndmask_b32 v34, v34, v46, s[54:55]
    v_cndmask_b32 v35, v35, v47, s[56:57]
    s_waitcnt vmcnt(0)
    v_lshlrev_b32 v40, 16, v236
    v_and_b32 v41, 0xffff0000, v236
    v_lshlrev_b32 v42, 16, v237
    v_and_b32 v43, 0xffff0000, v237
    v_lshlrev_b32 v44, 16, v238
    v_and_b32 v45, 0xffff0000, v238
    v_lshlrev_b32 v46, 16, v239
    v_and_b32 v47, 0xffff0000, v239
    v_add_f32 v28, v28, v40
    v_add_f32 v29, v29, v41
    v_add_f32 v30, v30, v42
    v_add_f32 v31, v31, v43
    v_add_f32 v32, v32, v44
    v_add_f32 v33, v33, v45
    v_add_f32 v34, v34, v46
    v_add_f32 v35, v35, v47
    v_cvt_pk_bf16_f32 v20, v28, v29
    v_cvt_pk_bf16_f32 v21, v30, v31
    v_cvt_pk_bf16_f32 v22, v32, v33
    v_cvt_pk_bf16_f32 v23, v34, v35
    buffer_store_dwordx4 v[20:23], v3, s[20:23], 0 offen sc1
K2_END:
    s_endpgm
.section .rodata,"a"
.p2align 6
.amdhsa_kernel gcn_sort_kernel
  .amdhsa_next_free_vgpr 40
  .amdhsa_next_free_sgpr 72
  .amdhsa_accum_offset 40
  .amdhsa_group_segment_fixed_size 0
  .amdhsa_kernarg_size 96
  .amdhsa_user_sgpr_count 2
  .amdhsa_user_sgpr_kernarg_segment_ptr 1
  .amdhsa_system_sgpr_workgroup_id_x 1
.end_amdhsa_kernel

.p2align 6
.amdhsa_kernel standalone__edge_featured_mpnn_gatedgcn__graph_kernel
  .amdhsa_next_free_vgpr 256
  .amdhsa_next_free_sgpr 96
  .amdhsa_accum_offset 256
  .amdhsa_group_segment_fixed_size 0
  .amdhsa_kernarg_size 96
  .amdhsa_user_sgpr_count 2
  .amdhsa_user_sgpr_kernarg_segment_ptr 1
  .amdhsa_system_sgpr_workgroup_id_x 1
.end_amdhsa_kernel
```
